```python
import torch

def _softmax(x, axis=-1):
    return torch.softmax(x, dim=axis)
def _gelu(x):
    return torch.nn.functional.gelu(x, approximate="tanh")
def _silu(x):
    return torch.nn.functional.silu(x)
def _sigmoid(x):
    return torch.sigmoid(x)
def _layernorm(x, axis=-1, eps=1e-5):
    m = x.mean(dim=axis, keepdim=True)
    v = x.var(dim=axis, keepdim=True, unbiased=False)
    return (x - m) / torch.sqrt(v + eps)
def _scatter_add(tgt, idx, src, axis=0):
    return tgt.clone().index_add_(axis, idx, src)
def _segment_sum(src, seg, n):
    out = torch.zeros((n,) + src.shape[1:], dtype=src.dtype)
    return out.index_add_(0, seg, src)
def _pad(x, pw):
    flat = tuple(v for pair in reversed(pw) for v in pair)
    return torch.nn.functional.pad(x, flat)

kernel_name = 'recurrent_scan__mha_block_cached__geglu_ffn__decode'

def setup_inputs():

    _w = (lambda a: (lambda t: t.to(torch.bfloat16) if t.is_floating_point() else t)(torch.as_tensor(a)))
    def _A_setup():
        B, Sq, D = 2, 1, 512
        H, Sk, Dh = 32, 16384, 128
        return {
            "x": _w((lambda *s: torch.randn(*s, dtype=torch.bfloat16) * 0.05)(B, Sq, D)),
            "k_cache": _w((lambda *s: torch.randn(*s, dtype=torch.bfloat16) * 1.6)(B, H, Sk, Dh)),
            "v_cache": _w((lambda *s: torch.randn(*s, dtype=torch.bfloat16) * 0.2)(B, H, Sk, Dh)),
            "wq": _w((lambda *s: torch.randn(*s, dtype=torch.bfloat16) * 1.6)(D, H * Dh) * (D ** -0.5)),
            "wo": _w((lambda *s: torch.randn(*s, dtype=torch.bfloat16) * 0.2)(H * Dh, D) * ((H * Dh) ** -0.5)),
        }
    _A_in = _A_setup()

    def _B_setup():
        B, S, D, F = 2, 1, 512, 1376
        return {
            "x": _w((lambda *s: torch.randn(*s, dtype=torch.bfloat16) * 0.05)(B, S, D)),
            "w_gate": _w((lambda *s: torch.randn(*s, dtype=torch.bfloat16) * 0.1)(D, F)),
            "w_up": _w((lambda *s: torch.randn(*s, dtype=torch.bfloat16) * 0.1)(D, F)),
            "w_down": _w((lambda *s: torch.randn(*s, dtype=torch.bfloat16) * 0.1)(F, D)),
        }
    _B_in = _B_setup()

    return {
        "A_x": _A_in["x"],
        "A_k_cache": _A_in["k_cache"],
        "A_v_cache": _A_in["v_cache"],
        "A_wq": _A_in["wq"],
        "A_wo": _A_in["wo"],
        "B_x": _B_in["x"],
        "B_w_gate": _B_in["w_gate"],
        "B_w_up": _B_in["w_up"],
        "B_w_down": _B_in["w_down"],
    }

def reference(A_x, A_k_cache, A_v_cache, A_wq, A_wo, B_x, B_w_gate, B_w_up, B_w_down):
    def _A_ref(x, k_cache, v_cache, wq, wo):
        B, Sq, D = x.shape
        H, Dh = 32, 128
        q = (lambda x, *d: x.permute(*d))((x @ wq).reshape(B, Sq, H, Dh), 0, 2, 1, 3)
        scores = torch.einsum("bhqd,bhkd->bhqk", q, k_cache) * (Dh ** -0.5)
        p = _softmax(scores, axis=-1)
        o = torch.einsum("bhqk,bhkd->bhqd", p, v_cache)
        return (lambda x, *d: x.permute(*d))(o, 0, 2, 1, 3).reshape(B, Sq, H * Dh) @ wo

    def _B_ref(x, w_gate, w_up, w_down):
        return (_gelu(x @ w_gate) * (x @ w_up)) @ w_down

    x = A_x
    xn = _layernorm(x, axis=-1)
    s = _A_ref(xn, A_k_cache, A_v_cache, A_wq, A_wo)
    g = _silu(_B_ref(xn, B_w_gate, B_w_up, B_w_down))
    return x + s * g
```

```asm
; @launch kernel=recurrent_scan__mha_block_cached__geglu_ffn__decode_kernel grid=(256,1,1) block=(1024,1,1) lds=163840
; @launch kernel=decode_final_kernel grid=(32,1,1) block=(256,1,1) lds=2048
.amdgcn_target "amdgcn-amd-amdhsa--gfx950"
.text
.globl recurrent_scan__mha_block_cached__geglu_ffn__decode_kernel
.p2align 8
.type recurrent_scan__mha_block_cached__geglu_ffn__decode_kernel,@function
recurrent_scan__mha_block_cached__geglu_ffn__decode_kernel:
    s_cmp_ge_u32 s2, 256
    s_cbranch_scc1 KA_END
    s_load_dwordx8 s[4:11], s[0:1], 0
    s_load_dwordx4 s[12:15], s[0:1], 48
    s_load_dwordx2 s[16:17], s[0:1], 88
    s_load_dwordx2 s[68:69], s[0:1], 32
    s_load_dwordx2 s[70:71], s[0:1], 64
    v_and_b32 v1, 63, v0
    v_lshrrev_b32 v4, 6, v0
    s_nop 0
    v_readfirstlane_b32 s43, v4
    s_and_b32 s46, s2, 7
    s_lshr_b32 s47, s2, 3
    s_lshr_b32 s48, s47, 3
    s_lshl_b32 s40, s46, 2
    s_add_u32 s40, s40, s48
    s_lshr_b32 s41, s47, 2
    s_and_b32 s41, s41, 1
    s_and_b32 s42, s47, 3
    s_lshl_b32 s49, s41, 5
    s_add_u32 s49, s49, s40
    s_lshl_b32 s50, s49, 2
    s_add_u32 s50, s50, s42
    s_lshl_b32 s51, s50, 20
    s_lshr_b32 s97, s47, 2
    s_lshl_b32 s97, s97, 3
    s_add_u32 s97, s97, s46
    s_mov_b32 s98, 256
    s_lshl_b32 s99, s42, 8
    s_mov_b32 s85, 0
    s_cmp_ge_u32 s97, 43
    s_cbranch_scc1 KA_NOSKEW
    s_mov_b32 s98, 262
    s_mul_i32 s99, s42, 262
    s_sub_u32 s99, s99, 24
    s_cmp_lg_u32 s42, 0
    s_cbranch_scc1 KA_NOSKEW
    s_mov_b32 s98, 238
    s_mov_b32 s99, 0
    s_mov_b32 s85, 1
KA_NOSKEW:
    s_lshl_b32 s51, s49, 22
    s_lshl_b32 s99, s99, 12
    s_add_u32 s51, s51, s99
    s_lshl_b32 s99, s98, 12
    v_lshlrev_b32 v5, 4, v1
    v_lshrrev_b32 v4, 4, v0
    v_and_b32 v7, 15, v0
    v_lshlrev_b32 v6, 16, v4
    v_lshl_add_u32 v6, v7, 4, v6
    s_lshl_b32 s44, s43, 13
    v_add_u32 v2, s44, v5
    v_add_u32 v3, 0x1000, v2
    s_lshl_b32 s44, s43, 12
    v_mov_b32 v39, v5
    s_mov_b32 s96, s44
    s_waitcnt lgkmcnt(0)
    s_add_u32 s20, s6, s51
    s_addc_u32 s21, s7, 0
    s_mov_b32 s22, s99
    s_mov_b32 s23, 0x20000
    s_add_u32 s24, s8, s51
    s_addc_u32 s25, s9, 0
    s_mov_b32 s26, s99
    s_mov_b32 s27, 0x20000
    s_mov_b32 s28, s10
    s_mov_b32 s29, s11
    s_mov_b32 s30, 0x400000
    s_mov_b32 s31, 0x20000
    s_mov_b32 s32, s4
    s_mov_b32 s33, s5
    s_mov_b32 s34, 2048
    s_mov_b32 s35, 0x20000
    s_mov_b32 s36, s16
    s_mov_b32 s37, s17
    s_mov_b32 s38, 3145728
    s_mov_b32 s39, 0x20000
    s_lshl_b32 s74, s40, 17
    s_add_u32 s76, s68, s74
    s_addc_u32 s77, s69, 0
    s_mov_b32 s78, 0x20000
    s_mov_b32 s79, 0x20000
    s_mov_b32 s44, s96
    buffer_load_dwordx4 v[118:121], v5, s[32:35], 0 offen
    buffer_load_dwordx4 v[122:125], v5, s[32:35], 0 offen offset:1024
    s_lshl_b32 s45, s40, 8
    buffer_load_dwordx4 v[72:75], v6, s[28:31], s45 offen
    s_add_u32 s45, s45, 0x2000
    buffer_load_dwordx4 v[76:79], v6, s[28:31], s45 offen
    s_add_u32 s45, s45, 0x2000
    buffer_load_dwordx4 v[80:83], v6, s[28:31], s45 offen
    s_add_u32 s45, s45, 0x2000
    buffer_load_dwordx4 v[84:87], v6, s[28:31], s45 offen
    s_add_u32 s45, s45, 0x2000
    buffer_load_dwordx4 v[88:91], v6, s[28:31], s45 offen
    s_add_u32 s45, s45, 0x2000
    buffer_load_dwordx4 v[92:95], v6, s[28:31], s45 offen
    s_add_u32 s45, s45, 0x2000
    buffer_load_dwordx4 v[96:99], v6, s[28:31], s45 offen
    s_add_u32 s45, s45, 0x2000
    buffer_load_dwordx4 v[100:103], v6, s[28:31], s45 offen
    s_cmp_eq_u32 s85, 0
    s_cbranch_scc1 KA_ISSUE_N
    s_mov_b32 s56, s12
    s_mov_b32 s57, s13
    s_mov_b32 s58, 0x158000
    s_mov_b32 s59, 0x20000
    s_mov_b32 s60, s14
    s_mov_b32 s61, s15
    s_mov_b32 s62, 0x158000
    s_mov_b32 s63, 0x20000
    v_lshrrev_b32 v126, 3, v1
    s_lshl_b32 s45, s43, 5
    v_add_u32 v126, s45, v126
    s_mov_b32 s46, 2752
    v_mul_lo_u32 v126, v126, s46
    v_and_b32 v127, 3, v0
    v_lshl_add_u32 v126, v127, 4, v126
    s_mov_b32 s64, 0x0f0f0f0f
    s_mov_b32 s65, 0x0f0f0f0f
    s_mov_b32 s66, 0xf0f0f0f0
    s_mov_b32 s67, 0xf0f0f0f0
    s_lshl_b32 s45, s97, 6
    s_lshl_b32 s47, s43, 12
    s_add_u32 s47, s47, 32768
    s_mov_b32 m0, s47
    s_mov_b64 exec, s[64:65]
    buffer_load_dwordx4 v126, s[56:59], s45 offen lds
    s_mov_b64 exec, s[66:67]
    buffer_load_dwordx4 v126, s[60:63], s45 offen lds
    s_add_u32 s45, s45, 22016
    s_add_u32 s47, s47, 1024
    s_mov_b32 m0, s47
    s_mov_b64 exec, s[64:65]
    buffer_load_dwordx4 v126, s[56:59], s45 offen lds
    s_mov_b64 exec, s[66:67]
    buffer_load_dwordx4 v126, s[60:63], s45 offen lds
    s_add_u32 s45, s45, 22016
    s_add_u32 s47, s47, 1024
    s_mov_b32 m0, s47
    s_mov_b64 exec, s[64:65]
    buffer_load_dwordx4 v126, s[56:59], s45 offen lds
    s_mov_b64 exec, s[66:67]
    buffer_load_dwordx4 v126, s[60:63], s45 offen lds
    s_add_u32 s45, s45, 22016
    s_add_u32 s47, s47, 1024
    s_mov_b32 m0, s47
    s_mov_b64 exec, s[64:65]
    buffer_load_dwordx4 v126, s[56:59], s45 offen lds
    s_mov_b64 exec, s[66:67]
    buffer_load_dwordx4 v126, s[60:63], s45 offen lds
    s_mov_b64 exec, -1
    s_lshl_b32 s74, s97, 15
    s_add_u32 s80, s70, s74
    s_addc_u32 s81, s71, 0
    s_mov_b32 s82, 0x8000
    s_mov_b32 s83, 0x20000
    s_lshl_b32 s45, s43, 11
    s_add_u32 s47, s45, 98304
    s_mov_b32 m0, s47
    s_nop 0
    buffer_load_dwordx4 v5, s[80:83], s45 offen lds
    buffer_load_dwordx4 v5, s[80:83], s45 offen offset:1024 lds
    s_branch KA_ISSUE_KV
KA_ISSUE_N:
    s_lshl_b32 s45, s43, 13
    s_add_u32 s45, s45, 32768
    s_mov_b32 m0, s45
    s_nop 0
    buffer_load_dwordx4 v2, s[76:79], 0 offen offset:0 lds
    buffer_load_dwordx4 v2, s[76:79], 0 offen offset:1024 lds
    buffer_load_dwordx4 v2, s[76:79], 0 offen offset:2048 lds
    buffer_load_dwordx4 v2, s[76:79], 0 offen offset:3072 lds
    s_add_u32 s45, s45, 0x1000
    s_mov_b32 m0, s45
    s_nop 0
    buffer_load_dwordx4 v3, s[76:79], 0 offen offset:0 lds
    buffer_load_dwordx4 v3, s[76:79], 0 offen offset:1024 lds
    buffer_load_dwordx4 v3, s[76:79], 0 offen offset:2048 lds
    buffer_load_dwordx4 v3, s[76:79], 0 offen offset:3072 lds
    buffer_load_dword v70, v1, s[32:35], 0 offen
    buffer_load_dword v71, v1, s[32:35], 0 offen
KA_ISSUE_KV:
    buffer_load_dwordx4 v[8:11], v39, s[20:23], s44 offen offset:0 nt
    buffer_load_dwordx4 v[12:15], v39, s[20:23], s44 offen offset:1024 nt
    buffer_load_dwordx4 v[16:19], v39, s[20:23], s44 offen offset:2048 nt
    buffer_load_dwordx4 v[20:23], v39, s[20:23], s44 offen offset:3072 nt
    buffer_load_dwordx4 v[40:43], v39, s[24:27], s44 offen offset:0 nt
    buffer_load_dwordx4 v[44:47], v39, s[24:27], s44 offen offset:1024 nt
    buffer_load_dwordx4 v[48:51], v39, s[24:27], s44 offen offset:2048 nt
    buffer_load_dwordx4 v[52:55], v39, s[24:27], s44 offen offset:3072 nt
    v_lshlrev_b32 v4, 5, v1
    s_waitcnt vmcnt(26)
    s_mov_b32 s84, s85
    s_cmp_lg_u32 s85, 0
    s_cbranch_scc1 KA_LN
    s_cmp_eq_u32 s41, 0
    s_cbranch_scc1 KA_LN
KA_LN_NEXT:
    v_mov_b32 v118, v122
    v_mov_b32 v119, v123
    v_mov_b32 v120, v124
    v_mov_b32 v121, v125
    v_add_u32 v4, 0x800, v4
KA_LN:
    v_lshlrev_b32 v110, 16, v118
    v_and_b32 v111, 0xffff0000, v118
    v_lshlrev_b32 v112, 16, v119
    v_and_b32 v113, 0xffff0000, v119
    v_lshlrev_b32 v114, 16, v120
    v_and_b32 v115, 0xffff0000, v120
    v_lshlrev_b32 v116, 16, v121
    v_and_b32 v117, 0xffff0000, v121
    v_add_f32 v104, v110, v111
    v_add_f32 v105, v112, v113
    v_add_f32 v106, v114, v115
    v_add_f32 v107, v116, v117
    v_add_f32 v104, v104, v105
    v_add_f32 v106, v106, v107
    v_add_f32 v104, v104, v106
    s_nop 2
    v_add_f32_dpp v104, v104, v104 quad_perm:[1,0,3,2] row_mask:0xf bank_mask:0xf
    s_nop 2
    v_add_f32_dpp v104, v104, v104 quad_perm:[2,3,0,1] row_mask:0xf bank_mask:0xf
    s_nop 2
    v_add_f32_dpp v104, v104, v104 row_half_mirror row_mask:0xf bank_mask:0xf
    s_nop 2
    v_add_f32_dpp v104, v104, v104 row_mirror row_mask:0xf bank_mask:0xf
    s_nop 1
    v_readlane_b32 s52, v104, 0
    v_readlane_b32 s53, v104, 16
    v_readlane_b32 s54, v104, 32
    v_readlane_b32 s55, v104, 48
    s_nop 1
    v_mov_b32 v105, s52
    v_add_f32 v105, s53, v105
    v_add_f32 v105, s54, v105
    v_add_f32 v104, s55, v105
    v_mul_f32 v107, 0x3b000000, v104
    v_sub_f32 v105, v110, v107
    v_mul_f32 v104, v105, v105
    v_sub_f32 v105, v111, v107
    v_fma_f32 v104, v105, v105, v104
    v_sub_f32 v105, v112, v107
    v_fma_f32 v104, v105, v105, v104
    v_sub_f32 v105, v113, v107
    v_fma_f32 v104, v105, v105, v104
    v_sub_f32 v105, v114, v107
    v_fma_f32 v104, v105, v105, v104
    v_sub_f32 v105, v115, v107
    v_fma_f32 v104, v105, v105, v104
    v_sub_f32 v105, v116, v107
    v_fma_f32 v104, v105, v105, v104
    v_sub_f32 v105, v117, v107
    v_fma_f32 v104, v105, v105, v104
    s_nop 2
    v_add_f32_dpp v104, v104, v104 quad_perm:[1,0,3,2] row_mask:0xf bank_mask:0xf
    s_nop 2
    v_add_f32_dpp v104, v104, v104 quad_perm:[2,3,0,1] row_mask:0xf bank_mask:0xf
    s_nop 2
    v_add_f32_dpp v104, v104, v104 row_half_mirror row_mask:0xf bank_mask:0xf
    s_nop 2
    v_add_f32_dpp v104, v104, v104 row_mirror row_mask:0xf bank_mask:0xf
    s_nop 1
    v_readlane_b32 s52, v104, 0
    v_readlane_b32 s53, v104, 16
    v_readlane_b32 s54, v104, 32
    v_readlane_b32 s55, v104, 48
    s_nop 1
    v_mov_b32 v105, s52
    v_add_f32 v105, s53, v105
    v_add_f32 v105, s54, v105
    v_add_f32 v104, s55, v105
    v_mul_f32 v108, 0x3b000000, v104
    v_cvt_pk_bf16_f32 v105, v107, v107
    v_lshlrev_b32 v107, 16, v105
    v_cvt_pk_bf16_f32 v105, v108, v108
    v_lshlrev_b32 v108, 16, v105
    v_add_f32 v108, 0x3727c5ac, v108
    v_cvt_pk_bf16_f32 v105, v108, v108
    v_lshlrev_b32 v108, 16, v105
    v_sqrt_f32 v108, v108
    s_nop 0
    v_cvt_pk_bf16_f32 v105, v108, v108
    v_lshlrev_b32 v108, 16, v105
    v_rcp_f32 v108, v108
    v_sub_f32 v110, v110, v107
    v_sub_f32 v111, v111, v107
    v_sub_f32 v112, v112, v107
    v_sub_f32 v113, v113, v107
    v_sub_f32 v114, v114, v107
    v_sub_f32 v115, v115, v107
    v_sub_f32 v116, v116, v107
    v_sub_f32 v117, v117, v107
    v_cvt_pk_bf16_f32 v105, v110, v111
    v_lshlrev_b32 v110, 16, v105
    v_and_b32 v111, 0xffff0000, v105
    v_cvt_pk_bf16_f32 v105, v112, v113
    v_lshlrev_b32 v112, 16, v105
    v_and_b32 v113, 0xffff0000, v105
    v_cvt_pk_bf16_f32 v105, v114, v115
    v_lshlrev_b32 v114, 16, v105
    v_and_b32 v115, 0xffff0000, v105
    v_cvt_pk_bf16_f32 v105, v116, v117
    v_lshlrev_b32 v116, 16, v105
    v_and_b32 v117, 0xffff0000, v105
    v_mul_f32 v110, v110, v108
    v_mul_f32 v111, v111, v108
    v_mul_f32 v112, v112, v108
    v_mul_f32 v113, v113, v108
    v_mul_f32 v114, v114, v108
    v_mul_f32 v115, v115, v108
    v_mul_f32 v116, v116, v108
    v_mul_f32 v117, v117, v108
    v_cvt_pk_bf16_f32 v105, v110, v111
    v_lshlrev_b32 v110, 16, v105
    v_and_b32 v111, 0xffff0000, v105
    v_cvt_pk_bf16_f32 v105, v112, v113
    v_lshlrev_b32 v112, 16, v105
    v_and_b32 v113, 0xffff0000, v105
    v_cvt_pk_bf16_f32 v105, v114, v115
    v_lshlrev_b32 v114, 16, v105
    v_and_b32 v115, 0xffff0000, v105
    v_cvt_pk_bf16_f32 v105, v116, v117
    v_lshlrev_b32 v116, 16, v105
    v_and_b32 v117, 0xffff0000, v105
    ds_write_b128 v4, v[110:113] offset:0
    ds_write_b128 v4, v[114:117] offset:16
    s_cmp_lg_u32 s84, 0
    s_mov_b32 s84, 0
    s_cbranch_scc1 KA_LN_NEXT
    v_lshrrev_b32 v4, 4, v0
    v_lshlrev_b32 v4, 5, v4
    s_lshl_b32 s46, s41, 11
    v_add_u32 v126, s46, v4
    v_lshlrev_b32 v6, 2, v0
    s_mov_b32 s84, 0
    v_mov_b32 v116, 16
    v_mov_b32 v117, 0
    ds_write_b32 v117, v116 offset:8960
    s_waitcnt vmcnt(18) lgkmcnt(0)
KA_JOB:
    ds_read_b128 v[118:121], v126 offset:0
    ds_read_b128 v[122:125], v126 offset:16
    s_waitcnt lgkmcnt(0)
    v_lshrrev_b32 v56, 16, v118
    v_lshrrev_b32 v57, 16, v119
    v_lshrrev_b32 v58, 16, v120
    v_lshrrev_b32 v59, 16, v121
    v_lshrrev_b32 v60, 16, v122
    v_lshrrev_b32 v61, 16, v123
    v_lshrrev_b32 v62, 16, v124
    v_lshrrev_b32 v63, 16, v125
    v_dot2_f32_bf16 v108, v72, v56, 0
    v_dot2_f32_bf16 v109, v72, v118, 0
    v_dot2_f32_bf16 v110, v73, v56, 0
    v_dot2_f32_bf16 v111, v73, v118, 0
    v_dot2_f32_bf16 v112, v74, v56, 0
    v_dot2_f32_bf16 v113, v74, v118, 0
    v_dot2_f32_bf16 v114, v75, v56, 0
    v_dot2_f32_bf16 v115, v75, v118, 0
    v_dot2_f32_bf16 v108, v76, v57, v108
    v_dot2_f32_bf16 v109, v76, v119, v109
    v_dot2_f32_bf16 v110, v77, v57, v110
    v_dot2_f32_bf16 v111, v77, v119, v111
    v_dot2_f32_bf16 v112, v78, v57, v112
    v_dot2_f32_bf16 v113, v78, v119, v113
    v_dot2_f32_bf16 v114, v79, v57, v114
    v_dot2_f32_bf16 v115, v79, v119, v115
    v_dot2_f32_bf16 v108, v80, v58, v108
    v_dot2_f32_bf16 v109, v80, v120, v109
    v_dot2_f32_bf16 v110, v81, v58, v110
    v_dot2_f32_bf16 v111, v81, v120, v111
    v_dot2_f32_bf16 v112, v82, v58, v112
    v_dot2_f32_bf16 v113, v82, v120, v113
    v_dot2_f32_bf16 v114, v83, v58, v114
    v_dot2_f32_bf16 v115, v83, v120, v115
    v_dot2_f32_bf16 v108, v84, v59, v108
    v_dot2_f32_bf16 v109, v84, v121, v109
    v_dot2_f32_bf16 v110, v85, v59, v110
    v_dot2_f32_bf16 v111, v85, v121, v111
    v_dot2_f32_bf16 v112, v86, v59, v112
    v_dot2_f32_bf16 v113, v86, v121, v113
    v_dot2_f32_bf16 v114, v87, v59, v114
    v_dot2_f32_bf16 v115, v87, v121, v115
    v_dot2_f32_bf16 v108, v88, v60, v108
    v_dot2_f32_bf16 v109, v88, v122, v109
    v_dot2_f32_bf16 v110, v89, v60, v110
    v_dot2_f32_bf16 v111, v89, v122, v111
    v_dot2_f32_bf16 v112, v90, v60, v112
    v_dot2_f32_bf16 v113, v90, v122, v113
    v_dot2_f32_bf16 v114, v91, v60, v114
    v_dot2_f32_bf16 v115, v91, v122, v115
    v_dot2_f32_bf16 v108, v92, v61, v108
    v_dot2_f32_bf16 v109, v92, v123, v109
    v_dot2_f32_bf16 v110, v93, v61, v110
    v_dot2_f32_bf16 v111, v93, v123, v111
    v_dot2_f32_bf16 v112, v94, v61, v112
    v_dot2_f32_bf16 v113, v94, v123, v113
    v_dot2_f32_bf16 v114, v95, v61, v114
    v_dot2_f32_bf16 v115, v95, v123, v115
    v_dot2_f32_bf16 v108, v96, v62, v108
    v_dot2_f32_bf16 v109, v96, v124, v109
    v_dot2_f32_bf16 v110, v97, v62, v110
    v_dot2_f32_bf16 v111, v97, v124, v111
    v_dot2_f32_bf16 v112, v98, v62, v112
    v_dot2_f32_bf16 v113, v98, v124, v113
    v_dot2_f32_bf16 v114, v99, v62, v114
    v_dot2_f32_bf16 v115, v99, v124, v115
    v_dot2_f32_bf16 v108, v100, v63, v108
    v_dot2_f32_bf16 v109, v100, v125, v109
    v_dot2_f32_bf16 v110, v101, v63, v110
    v_dot2_f32_bf16 v111, v101, v125, v111
    v_dot2_f32_bf16 v112, v102, v63, v112
    v_dot2_f32_bf16 v113, v102, v125, v113
    v_dot2_f32_bf16 v114, v103, v63, v114
    v_dot2_f32_bf16 v115, v103, v125, v115
    s_cmp_eq_u32 s85, 0
    s_cbranch_scc1 KA_JOB_NOW
    s_waitcnt vmcnt(8)
KA_JOB_NOW:
    s_nop 1
    v_mov_b32 v80, v108
    v_mov_b32 v81, v109
    v_mov_b32 v82, v110
    v_mov_b32 v83, v111
    v_mov_b32 v84, v112
    v_mov_b32 v85, v113
    v_mov_b32 v86, v114
    v_mov_b32 v87, v115
    s_nop 1
    v_permlane32_swap_b32 v80, v108
    v_permlane32_swap_b32 v81, v109
    v_permlane32_swap_b32 v82, v110
    v_permlane32_swap_b32 v83, v111
    v_permlane32_swap_b32 v84, v112
    v_permlane32_swap_b32 v85, v113
    v_permlane32_swap_b32 v86, v114
    v_permlane32_swap_b32 v87, v115
    s_nop 1
    v_add_f32 v108, v108, v80
    v_add_f32 v109, v109, v81
    v_add_f32 v110, v110, v82
    v_add_f32 v111, v111, v83
    v_add_f32 v112, v112, v84
    v_add_f32 v113, v113, v85
    v_add_f32 v114, v114, v86
    v_add_f32 v115, v115, v87
    v_bfe_u32 v72, v0, 4, 1
    s_lshl_b32 s45, s43, 1
    v_add_u32 v72, s45, v72
    v_lshlrev_b32 v72, 9, v72
    v_lshl_add_u32 v72, v7, 5, v72
    ds_write_b128 v72, v[108:111] offset:9216
    ds_write_b128 v72, v[112:115] offset:9232
    v_lshrrev_b32 v73, 7, v0
    v_lshlrev_b32 v73, 11, v73
    v_and_b32 v74, 127, v0
    v_lshl_add_u32 v73, v74, 2, v73
    s_waitcnt lgkmcnt(0)
    s_barrier
    ds_read_b32 v76, v73 offset:9216
    ds_read_b32 v77, v73 offset:9728
    ds_read_b32 v78, v73 offset:10240
    ds_read_b32 v79, v73 offset:10752
    s_waitcnt lgkmcnt(0)
    v_add_f32 v76, v76, v77
    v_add_f32 v78, v78, v79
    v_add_f32 v76, v76, v78
    ds_write_b32 v6, v76 offset:4096
    s_waitcnt lgkmcnt(0)
    s_barrier
    s_cmp_lg_u32 s84, 0
    s_cbranch_scc1 KA_FFN_TAIL
    v_and_b32 v126, 15, v1
    v_lshlrev_b32 v126, 5, v126
    ds_read_b128 v[72:75], v126 offset:4096
    ds_read_b128 v[76:79], v126 offset:4112
    ds_read_b128 v[80:83], v126 offset:4608
    ds_read_b128 v[84:87], v126 offset:4624
    ds_read_b128 v[88:91], v126 offset:5120
    ds_read_b128 v[92:95], v126 offset:5136
    ds_read_b128 v[96:99], v126 offset:5632
    ds_read_b128 v[100:103], v126 offset:5648
    s_waitcnt lgkmcnt(0)
    v_add_f32 v72, v72, v80
    v_add_f32 v88, v88, v96
    v_add_f32 v73, v73, v81
    v_add_f32 v89, v89, v97
    v_add_f32 v74, v74, v82
    v_add_f32 v90, v90, v98
    v_add_f32 v75, v75, v83
    v_add_f32 v91, v91, v99
    v_add_f32 v76, v76, v84
    v_add_f32 v92, v92, v100
    v_add_f32 v77, v77, v85
    v_add_f32 v93, v93, v101
    v_add_f32 v78, v78, v86
    v_add_f32 v94, v94, v102
    v_add_f32 v79, v79, v87
    v_add_f32 v95, v95, v103
    v_add_f32 v108, v72, v88
    v_add_f32 v109, v73, v89
    v_add_f32 v110, v74, v90
    v_add_f32 v111, v75, v91
    v_add_f32 v112, v76, v92
    v_add_f32 v113, v77, v93
    v_add_f32 v114, v78, v94
    v_add_f32 v115, v79, v95
    ds_read_b128 v[72:75], v126 offset:6144
    ds_read_b128 v[76:79], v126 offset:6160
    ds_read_b128 v[80:83], v126 offset:6656
    ds_read_b128 v[84:87], v126 offset:6672
    ds_read_b128 v[88:91], v126 offset:7168
    ds_read_b128 v[92:95], v126 offset:7184
    ds_read_b128 v[96:99], v126 offset:7680
    ds_read_b128 v[100:103], v126 offset:7696
    s_waitcnt lgkmcnt(0)
    v_add_f32 v72, v72, v80
    v_add_f32 v88, v88, v96
    v_add_f32 v73, v73, v81
    v_add_f32 v89, v89, v97
    v_add_f32 v74, v74, v82
    v_add_f32 v90, v90, v98
    v_add_f32 v75, v75, v83
    v_add_f32 v91, v91, v99
    v_add_f32 v76, v76, v84
    v_add_f32 v92, v92, v100
    v_add_f32 v77, v77, v85
    v_add_f32 v93, v93, v101
    v_add_f32 v78, v78, v86
    v_add_f32 v94, v94, v102
    v_add_f32 v79, v79, v87
    v_add_f32 v95, v95, v103
    v_add_f32 v72, v72, v88
    v_add_f32 v108, v108, v72
    v_add_f32 v73, v73, v89
    v_add_f32 v109, v109, v73
    v_add_f32 v74, v74, v90
    v_add_f32 v110, v110, v74
    v_add_f32 v75, v75, v91
    v_add_f32 v111, v111, v75
    v_add_f32 v76, v76, v92
    v_add_f32 v112, v112, v76
    v_add_f32 v77, v77, v93
    v_add_f32 v113, v113, v77
    v_add_f32 v78, v78, v94
    v_add_f32 v114, v114, v78
    v_add_f32 v79, v79, v95
    v_add_f32 v115, v115, v79
    v_cvt_pk_bf16_f32 v104, v108, v109
    v_cvt_pk_bf16_f32 v105, v110, v111
    v_cvt_pk_bf16_f32 v106, v112, v113
    v_cvt_pk_bf16_f32 v107, v114, v115
    s_cmp_eq_u32 s85, 0
    s_cbranch_scc1 KA_PRO_DONE
    v_lshrrev_b32 v126, 4, v0
    v_lshlrev_b32 v126, 10, v126
    v_and_b32 v127, 7, v0
    v_lshl_add_u32 v126, v127, 4, v126
    ds_read_b128 v[72:75], v126 offset:32768
    ds_read_b128 v[76:79], v126 offset:32896
    ds_read_b128 v[80:83], v126 offset:33024
    ds_read_b128 v[84:87], v126 offset:33152
    ds_read_b128 v[88:91], v126 offset:33280
    ds_read_b128 v[92:95], v126 offset:33408
    ds_read_b128 v[96:99], v126 offset:33536
    ds_read_b128 v[100:103], v126 offset:33664
    v_lshrrev_b32 v127, 3, v7
    v_lshl_add_u32 v126, v127, 11, v4
    s_mov_b32 s84, 1
    s_branch KA_JOB
KA_FFN_TAIL:
    v_lshrrev_b32 v126, 5, v0
    v_and_b32 v127, 31, v0
    v_lshl_add_u32 v126, v126, 6, v127
    v_lshlrev_b32 v126, 2, v126
    s_cmp_lg_u32 s43, 0
    s_cbranch_scc1 KA_FFN_H_DONE
    ds_read_b32 v72, v126 offset:4096
    ds_read_b32 v80, v126 offset:4224
    ds_read_b32 v73, v126 offset:4608
    ds_read_b32 v81, v126 offset:4736
    ds_read_b32 v74, v126 offset:5120
    ds_read_b32 v82, v126 offset:5248
    ds_read_b32 v75, v126 offset:5632
    ds_read_b32 v83, v126 offset:5760
    ds_read_b32 v76, v126 offset:6144
    ds_read_b32 v84, v126 offset:6272
    ds_read_b32 v77, v126 offset:6656
    ds_read_b32 v85, v126 offset:6784
    ds_read_b32 v78, v126 offset:7168
    ds_read_b32 v86, v126 offset:7296
    ds_read_b32 v79, v126 offset:7680
    ds_read_b32 v87, v126 offset:7808
    s_waitcnt lgkmcnt(0)
    v_add_f32 v72, v72, v73
    v_add_f32 v74, v74, v75
    v_add_f32 v76, v76, v77
    v_add_f32 v78, v78, v79
    v_add_f32 v72, v72, v74
    v_add_f32 v76, v76, v78
    v_add_f32 v72, v72, v76
    v_add_f32 v80, v80, v81
    v_add_f32 v82, v82, v83
    v_add_f32 v84, v84, v85
    v_add_f32 v86, v86, v87
    v_add_f32 v80, v80, v82
    v_add_f32 v84, v84, v86
    v_add_f32 v80, v80, v84
    v_cvt_pk_bf16_f32 v73, v72, v72
    v_lshlrev_b32 v72, 16, v73
    v_cvt_pk_bf16_f32 v73, v80, v80
    v_lshlrev_b32 v80, 16, v73
    v_mul_f32 v73, v72, v72
    v_mul_f32 v73, v73, v72
    v_mov_b32 v74, 0x3d372713
    v_fma_f32 v73, v73, v74, v72
    v_mul_f32 v73, 0x3f4c422a, v73
    v_mul_f32 v73, 0x4038aa3b, v73
    v_exp_f32 v73, v73
    s_nop 0
    v_add_f32 v73, 1.0, v73
    v_rcp_f32 v73, v73
    s_nop 0
    v_fma_f32 v73, v73, -2.0, 1.0
    v_add_f32 v73, 1.0, v73
    v_mul_f32 v73, v73, v72
    v_mul_f32 v73, 0.5, v73
    v_cvt_pk_bf16_f32 v74, v73, v73
    v_lshlrev_b32 v73, 16, v74
    v_mul_f32 v73, v73, v80
    v_cvt_pk_bf16_f32 v74, v73, v73
    v_lshlrev_b32 v73, 16, v74
    ds_write_b32 v6, v73 offset:8704
    s_waitcnt lgkmcnt(0)
KA_FFN_H_DONE:
    s_barrier
    s_lshl_b32 s45, s43, 3
    v_mov_b32 v126, s45
    ds_read_b64 v[96:97], v126 offset:8704
    ds_read_b64 v[98:99], v126 offset:8832
    s_lshl_b32 s45, s43, 11
    s_add_u32 s45, s45, 98304
    v_lshlrev_b32 v126, 4, v1
    v_add_u32 v126, s45, v126
    ds_read_b128 v[88:91], v126
    ds_read_b128 v[92:95], v126 offset:1024
    s_waitcnt lgkmcnt(0)
    v_lshrrev_b32 v100, 16, v96
    v_lshrrev_b32 v101, 16, v97
    v_lshrrev_b32 v102, 16, v98
    v_lshrrev_b32 v103, 16, v99
    v_dot2_f32_bf16 v108, v88, v100, 0
    v_dot2_f32_bf16 v109, v88, v96, 0
    v_dot2_f32_bf16 v110, v89, v100, 0
    v_dot2_f32_bf16 v111, v89, v96, 0
    v_dot2_f32_bf16 v112, v90, v100, 0
    v_dot2_f32_bf16 v113, v90, v96, 0
    v_dot2_f32_bf16 v114, v91, v100, 0
    v_dot2_f32_bf16 v115, v91, v96, 0
    v_dot2_f32_bf16 v118, v88, v102, 0
    v_dot2_f32_bf16 v119, v88, v98, 0
    v_dot2_f32_bf16 v120, v89, v102, 0
    v_dot2_f32_bf16 v121, v89, v98, 0
    v_dot2_f32_bf16 v122, v90, v102, 0
    v_dot2_f32_bf16 v123, v90, v98, 0
    v_dot2_f32_bf16 v124, v91, v102, 0
    v_dot2_f32_bf16 v125, v91, v98, 0
    v_dot2_f32_bf16 v108, v92, v101, v108
    v_dot2_f32_bf16 v109, v92, v97, v109
    v_dot2_f32_bf16 v110, v93, v101, v110
    v_dot2_f32_bf16 v111, v93, v97, v111
    v_dot2_f32_bf16 v112, v94, v101, v112
    v_dot2_f32_bf16 v113, v94, v97, v113
    v_dot2_f32_bf16 v114, v95, v101, v114
    v_dot2_f32_bf16 v115, v95, v97, v115
    v_dot2_f32_bf16 v118, v92, v103, v118
    v_dot2_f32_bf16 v119, v92, v99, v119
    v_dot2_f32_bf16 v120, v93, v103, v120
    v_dot2_f32_bf16 v121, v93, v99, v121
    v_dot2_f32_bf16 v122, v94, v103, v122
    v_dot2_f32_bf16 v123, v94, v99, v123
    v_dot2_f32_bf16 v124, v95, v103, v124
    v_dot2_f32_bf16 v125, v95, v99, v125
    s_lshl_b32 s45, s43, 12
    v_lshlrev_b32 v126, 5, v1
    v_add_u32 v126, s45, v126
    s_nop 1
    ds_write_b128 v126, v[108:111] offset:32768
    ds_write_b128 v126, v[112:115] offset:32784
    ds_write_b64 v126, v[118:119] offset:34816
    ds_write_b64 v126, v[120:121] offset:34824
    ds_write_b64 v126, v[122:123] offset:34832
    ds_write_b64 v126, v[124:125] offset:34840
    s_waitcnt lgkmcnt(0)
    s_barrier
    v_add_u32 v126, 0x8000, v6
    ds_read_b32 v72, v6 offset:32768
    ds_read_b32 v73, v6 offset:36864
    ds_read_b32 v74, v6 offset:40960
    ds_read_b32 v75, v6 offset:45056
    ds_read_b32 v76, v6 offset:49152
    ds_read_b32 v77, v6 offset:53248
    ds_read_b32 v78, v6 offset:57344
    ds_read_b32 v79, v6 offset:61440
    ds_read_b32 v80, v126 offset:32768
    ds_read_b32 v81, v126 offset:36864
    ds_read_b32 v82, v126 offset:40960
    ds_read_b32 v83, v126 offset:45056
    ds_read_b32 v84, v126 offset:49152
    ds_read_b32 v85, v126 offset:53248
    ds_read_b32 v86, v126 offset:57344
    ds_read_b32 v87, v126 offset:61440
    s_waitcnt lgkmcnt(0)
    v_add_f32 v72, v72, v80
    v_add_f32 v73, v73, v81
    v_add_f32 v74, v74, v82
    v_add_f32 v75, v75, v83
    v_add_f32 v76, v76, v84
    v_add_f32 v77, v77, v85
    v_add_f32 v78, v78, v86
    v_add_f32 v79, v79, v87
    v_add_f32 v72, v72, v76
    v_add_f32 v73, v73, v77
    v_add_f32 v74, v74, v78
    v_add_f32 v75, v75, v79
    v_add_f32 v72, v72, v74
    v_add_f32 v73, v73, v75
    v_add_f32 v72, v72, v73
    s_lshl_b32 s45, s97, 12
    s_add_u32 s45, s45, 2097152
    buffer_store_dword v72, v6, s[36:39], s45 offen
    s_barrier
    s_lshl_b32 s45, s43, 13
    s_add_u32 s45, s45, 32768
    s_mov_b32 m0, s45
    s_nop 0
    buffer_load_dwordx4 v2, s[76:79], 0 offen offset:0 lds
    buffer_load_dwordx4 v2, s[76:79], 0 offen offset:1024 lds
    buffer_load_dwordx4 v2, s[76:79], 0 offen offset:2048 lds
    buffer_load_dwordx4 v2, s[76:79], 0 offen offset:3072 lds
    s_add_u32 s45, s45, 0x1000
    s_mov_b32 m0, s45
    s_nop 0
    buffer_load_dwordx4 v3, s[76:79], 0 offen offset:0 lds
    buffer_load_dwordx4 v3, s[76:79], 0 offen offset:1024 lds
    buffer_load_dwordx4 v3, s[76:79], 0 offen offset:2048 lds
    buffer_load_dwordx4 v3, s[76:79], 0 offen offset:3072 lds
    s_waitcnt vmcnt(0)
KA_PRO_DONE:
    v_mov_b32 v116, 0xff800000
    v_mov_b32 v117, 0
    v_mov_b32 v108, 0
    v_mov_b32 v109, 0
    v_mov_b32 v110, 0
    v_mov_b32 v111, 0
    v_mov_b32 v112, 0
    v_mov_b32 v113, 0
    v_mov_b32 v114, 0
    v_mov_b32 v115, 0
    s_mov_b32 s46, 0x3fb8aa3b
    s_mov_b32 s45, 0
    v_mov_b32 v101, 1
    v_mov_b32 v102, 0
KA_LOOP:
    s_mov_b64 exec, 1
    ds_add_rtn_u32 v100, v102, v101 offset:8960
    s_mov_b64 exec, -1
    s_waitcnt lgkmcnt(0)
    v_readfirstlane_b32 s45, v100
    s_nop 0
    s_lshl_b32 s44, s45, 12
    s_cmp_ge_u32 s45, s98
    s_cbranch_scc1 KA_LAST
    s_waitcnt vmcnt(4)
    v_dot2_f32_bf16 v118, v8, v104, 0
    v_dot2_f32_bf16 v119, v12, v104, 0
    v_dot2_f32_bf16 v120, v16, v104, 0
    v_dot2_f32_bf16 v121, v20, v104, 0
    v_dot2_f32_bf16 v118, v9, v105, v118
    v_dot2_f32_bf16 v119, v13, v105, v119
    v_dot2_f32_bf16 v120, v17, v105, v120
    v_dot2_f32_bf16 v121, v21, v105, v121
    v_dot2_f32_bf16 v118, v10, v106, v118
    v_dot2_f32_bf16 v119, v14, v106, v119
    v_dot2_f32_bf16 v120, v18, v106, v120
    v_dot2_f32_bf16 v121, v22, v106, v121
    v_dot2_f32_bf16 v118, v11, v107, v118
    v_dot2_f32_bf16 v119, v15, v107, v119
    v_dot2_f32_bf16 v120, v19, v107, v120
    v_dot2_f32_bf16 v121, v23, v107, v121
    buffer_load_dwordx4 v[8:11], v39, s[20:23], s44 offen offset:0 nt
    buffer_load_dwordx4 v[12:15], v39, s[20:23], s44 offen offset:1024 nt
    buffer_load_dwordx4 v[16:19], v39, s[20:23], s44 offen offset:2048 nt
    buffer_load_dwordx4 v[20:23], v39, s[20:23], s44 offen offset:3072 nt
    v_add_f32_dpp v118, v118, v118 quad_perm:[1,0,3,2] row_mask:0xf bank_mask:0xf
    v_add_f32_dpp v119, v119, v119 quad_perm:[1,0,3,2] row_mask:0xf bank_mask:0xf
    v_add_f32_dpp v120, v120, v120 quad_perm:[1,0,3,2] row_mask:0xf bank_mask:0xf
    v_add_f32_dpp v121, v121, v121 quad_perm:[1,0,3,2] row_mask:0xf bank_mask:0xf
    v_add_f32_dpp v118, v118, v118 quad_perm:[2,3,0,1] row_mask:0xf bank_mask:0xf
    v_add_f32_dpp v119, v119, v119 quad_perm:[2,3,0,1] row_mask:0xf bank_mask:0xf
    v_add_f32_dpp v120, v120, v120 quad_perm:[2,3,0,1] row_mask:0xf bank_mask:0xf
    v_add_f32_dpp v121, v121, v121 quad_perm:[2,3,0,1] row_mask:0xf bank_mask:0xf
    v_add_f32_dpp v118, v118, v118 row_half_mirror row_mask:0xf bank_mask:0xf
    v_add_f32_dpp v119, v119, v119 row_half_mirror row_mask:0xf bank_mask:0xf
    v_add_f32_dpp v120, v120, v120 row_half_mirror row_mask:0xf bank_mask:0xf
    v_add_f32_dpp v121, v121, v121 row_half_mirror row_mask:0xf bank_mask:0xf
    v_add_f32_dpp v118, v118, v118 row_mirror row_mask:0xf bank_mask:0xf
    v_add_f32_dpp v119, v119, v119 row_mirror row_mask:0xf bank_mask:0xf
    v_add_f32_dpp v120, v120, v120 row_mirror row_mask:0xf bank_mask:0xf
    v_add_f32_dpp v121, v121, v121 row_mirror row_mask:0xf bank_mask:0xf
    v_cvt_pk_bf16_f32 v88, v118, v119
    v_cvt_pk_bf16_f32 v90, v120, v121
    v_lshlrev_b32 v118, 16, v88
    v_and_b32 v119, 0xffff0000, v88
    v_lshlrev_b32 v120, 16, v90
    v_and_b32 v121, 0xffff0000, v90
    v_mul_f32 v118, 0x3db504f3, v118
    v_mul_f32 v119, 0x3db504f3, v119
    v_mul_f32 v120, 0x3db504f3, v120
    v_mul_f32 v121, 0x3db504f3, v121
    v_cvt_pk_bf16_f32 v88, v118, v119
    v_cvt_pk_bf16_f32 v90, v120, v121
    v_lshlrev_b32 v118, 16, v88
    v_and_b32 v119, 0xffff0000, v88
    v_lshlrev_b32 v120, 16, v90
    v_and_b32 v121, 0xffff0000, v90
    v_max3_f32 v96, v116, v118, v119
    v_max3_f32 v96, v96, v120, v121
    v_mul_f32 v97, s46, v96
    v_fma_f32 v98, v116, s46, -v97
    v_fma_f32 v118, v118, s46, -v97
    v_fma_f32 v119, v119, s46, -v97
    v_fma_f32 v120, v120, s46, -v97
    v_fma_f32 v121, v121, s46, -v97
    v_exp_f32 v98, v98
    v_exp_f32 v118, v118
    v_exp_f32 v119, v119
    v_exp_f32 v120, v120
    v_exp_f32 v121, v121
    v_mov_b32 v116, v96
    v_mul_f32 v108, v108, v98
    v_mul_f32 v109, v109, v98
    v_mul_f32 v110, v110, v98
    v_mul_f32 v111, v111, v98
    v_mul_f32 v112, v112, v98
    v_mul_f32 v113, v113, v98
    v_mul_f32 v114, v114, v98
    v_mul_f32 v115, v115, v98
    v_cvt_pk_bf16_f32 v72, v118, 0
    v_cvt_pk_bf16_f32 v80, 0, v118
    v_cvt_pk_bf16_f32 v73, v119, 0
    v_cvt_pk_bf16_f32 v81, 0, v119
    v_cvt_pk_bf16_f32 v74, v120, 0
    v_cvt_pk_bf16_f32 v82, 0, v120
    v_cvt_pk_bf16_f32 v75, v121, 0
    v_cvt_pk_bf16_f32 v83, 0, v121
    v_add_f32 v88, v118, v119
    v_add_f32 v89, v120, v121
    v_add_f32 v88, v88, v89
    v_fma_f32 v117, v117, v98, v88
    s_waitcnt vmcnt(4)
    v_dot2_f32_bf16 v108, v40, v72, v108
    v_dot2_f32_bf16 v109, v40, v80, v109
    v_dot2_f32_bf16 v110, v41, v72, v110
    v_dot2_f32_bf16 v111, v41, v80, v111
    v_dot2_f32_bf16 v112, v42, v72, v112
    v_dot2_f32_bf16 v113, v42, v80, v113
    v_dot2_f32_bf16 v114, v43, v72, v114
    v_dot2_f32_bf16 v115, v43, v80, v115
    v_dot2_f32_bf16 v108, v44, v73, v108
    v_dot2_f32_bf16 v109, v44, v81, v109
    v_dot2_f32_bf16 v110, v45, v73, v110
    v_dot2_f32_bf16 v111, v45, v81, v111
    v_dot2_f32_bf16 v112, v46, v73, v112
    v_dot2_f32_bf16 v113, v46, v81, v113
    v_dot2_f32_bf16 v114, v47, v73, v114
    v_dot2_f32_bf16 v115, v47, v81, v115
    v_dot2_f32_bf16 v108, v48, v74, v108
    v_dot2_f32_bf16 v109, v48, v82, v109
    v_dot2_f32_bf16 v110, v49, v74, v110
    v_dot2_f32_bf16 v111, v49, v82, v111
    v_dot2_f32_bf16 v112, v50, v74, v112
    v_dot2_f32_bf16 v113, v50, v82, v113
    v_dot2_f32_bf16 v114, v51, v74, v114
    v_dot2_f32_bf16 v115, v51, v82, v115
    v_dot2_f32_bf16 v108, v52, v75, v108
    v_dot2_f32_bf16 v109, v52, v83, v109
    v_dot2_f32_bf16 v110, v53, v75, v110
    v_dot2_f32_bf16 v111, v53, v83, v111
    v_dot2_f32_bf16 v112, v54, v75, v112
    v_dot2_f32_bf16 v113, v54, v83, v113
    v_dot2_f32_bf16 v114, v55, v75, v114
    v_dot2_f32_bf16 v115, v55, v83, v115
    buffer_load_dwordx4 v[40:43], v39, s[24:27], s44 offen offset:0 nt
    buffer_load_dwordx4 v[44:47], v39, s[24:27], s44 offen offset:1024 nt
    buffer_load_dwordx4 v[48:51], v39, s[24:27], s44 offen offset:2048 nt
    buffer_load_dwordx4 v[52:55], v39, s[24:27], s44 offen offset:3072 nt
    s_branch KA_LOOP
KA_LAST:
    s_waitcnt vmcnt(4)
    v_dot2_f32_bf16 v118, v8, v104, 0
    v_dot2_f32_bf16 v119, v12, v104, 0
    v_dot2_f32_bf16 v120, v16, v104, 0
    v_dot2_f32_bf16 v121, v20, v104, 0
    v_dot2_f32_bf16 v118, v9, v105, v118
    v_dot2_f32_bf16 v119, v13, v105, v119
    v_dot2_f32_bf16 v120, v17, v105, v120
    v_dot2_f32_bf16 v121, v21, v105, v121
    v_dot2_f32_bf16 v118, v10, v106, v118
    v_dot2_f32_bf16 v119, v14, v106, v119
    v_dot2_f32_bf16 v120, v18, v106, v120
    v_dot2_f32_bf16 v121, v22, v106, v121
    v_dot2_f32_bf16 v118, v11, v107, v118
    v_dot2_f32_bf16 v119, v15, v107, v119
    v_dot2_f32_bf16 v120, v19, v107, v120
    v_dot2_f32_bf16 v121, v23, v107, v121
    s_nop 3
    v_add_f32_dpp v118, v118, v118 quad_perm:[1,0,3,2] row_mask:0xf bank_mask:0xf
    v_add_f32_dpp v119, v119, v119 quad_perm:[1,0,3,2] row_mask:0xf bank_mask:0xf
    v_add_f32_dpp v120, v120, v120 quad_perm:[1,0,3,2] row_mask:0xf bank_mask:0xf
    v_add_f32_dpp v121, v121, v121 quad_perm:[1,0,3,2] row_mask:0xf bank_mask:0xf
    v_add_f32_dpp v118, v118, v118 quad_perm:[2,3,0,1] row_mask:0xf bank_mask:0xf
    v_add_f32_dpp v119, v119, v119 quad_perm:[2,3,0,1] row_mask:0xf bank_mask:0xf
    v_add_f32_dpp v120, v120, v120 quad_perm:[2,3,0,1] row_mask:0xf bank_mask:0xf
    v_add_f32_dpp v121, v121, v121 quad_perm:[2,3,0,1] row_mask:0xf bank_mask:0xf
    v_add_f32_dpp v118, v118, v118 row_half_mirror row_mask:0xf bank_mask:0xf
    v_add_f32_dpp v119, v119, v119 row_half_mirror row_mask:0xf bank_mask:0xf
    v_add_f32_dpp v120, v120, v120 row_half_mirror row_mask:0xf bank_mask:0xf
    v_add_f32_dpp v121, v121, v121 row_half_mirror row_mask:0xf bank_mask:0xf
    v_add_f32_dpp v118, v118, v118 row_mirror row_mask:0xf bank_mask:0xf
    v_add_f32_dpp v119, v119, v119 row_mirror row_mask:0xf bank_mask:0xf
    v_add_f32_dpp v120, v120, v120 row_mirror row_mask:0xf bank_mask:0xf
    v_add_f32_dpp v121, v121, v121 row_mirror row_mask:0xf bank_mask:0xf
    v_cvt_pk_bf16_f32 v88, v118, v119
    v_cvt_pk_bf16_f32 v90, v120, v121
    v_lshlrev_b32 v118, 16, v88
    v_and_b32 v119, 0xffff0000, v88
    v_lshlrev_b32 v120, 16, v90
    v_and_b32 v121, 0xffff0000, v90
    v_mul_f32 v118, 0x3db504f3, v118
    v_mul_f32 v119, 0x3db504f3, v119
    v_mul_f32 v120, 0x3db504f3, v120
    v_mul_f32 v121, 0x3db504f3, v121
    v_cvt_pk_bf16_f32 v88, v118, v119
    v_cvt_pk_bf16_f32 v90, v120, v121
    v_lshlrev_b32 v118, 16, v88
    v_and_b32 v119, 0xffff0000, v88
    v_lshlrev_b32 v120, 16, v90
    v_and_b32 v121, 0xffff0000, v90
    v_max3_f32 v96, v116, v118, v119
    v_max3_f32 v96, v96, v120, v121
    v_mul_f32 v97, s46, v96
    v_fma_f32 v98, v116, s46, -v97
    v_fma_f32 v118, v118, s46, -v97
    v_fma_f32 v119, v119, s46, -v97
    v_fma_f32 v120, v120, s46, -v97
    v_fma_f32 v121, v121, s46, -v97
    v_exp_f32 v98, v98
    v_exp_f32 v118, v118
    v_exp_f32 v119, v119
    v_exp_f32 v120, v120
    v_exp_f32 v121, v121
    v_mov_b32 v116, v96
    v_mul_f32 v108, v108, v98
    v_mul_f32 v109, v109, v98
    v_mul_f32 v110, v110, v98
    v_mul_f32 v111, v111, v98
    v_mul_f32 v112, v112, v98
    v_mul_f32 v113, v113, v98
    v_mul_f32 v114, v114, v98
    v_mul_f32 v115, v115, v98
    v_cvt_pk_bf16_f32 v72, v118, 0
    v_cvt_pk_bf16_f32 v80, 0, v118
    v_cvt_pk_bf16_f32 v73, v119, 0
    v_cvt_pk_bf16_f32 v81, 0, v119
    v_cvt_pk_bf16_f32 v74, v120, 0
    v_cvt_pk_bf16_f32 v82, 0, v120
    v_cvt_pk_bf16_f32 v75, v121, 0
    v_cvt_pk_bf16_f32 v83, 0, v121
    v_add_f32 v88, v118, v119
    v_add_f32 v89, v120, v121
    v_add_f32 v88, v88, v89
    v_fma_f32 v117, v117, v98, v88
    s_waitcnt vmcnt(0)
    v_dot2_f32_bf16 v108, v40, v72, v108
    v_dot2_f32_bf16 v109, v40, v80, v109
    v_dot2_f32_bf16 v110, v41, v72, v110
    v_dot2_f32_bf16 v111, v41, v80, v111
    v_dot2_f32_bf16 v112, v42, v72, v112
    v_dot2_f32_bf16 v113, v42, v80, v113
    v_dot2_f32_bf16 v114, v43, v72, v114
    v_dot2_f32_bf16 v115, v43, v80, v115
    v_dot2_f32_bf16 v108, v44, v73, v108
    v_dot2_f32_bf16 v109, v44, v81, v109
    v_dot2_f32_bf16 v110, v45, v73, v110
    v_dot2_f32_bf16 v111, v45, v81, v111
    v_dot2_f32_bf16 v112, v46, v73, v112
    v_dot2_f32_bf16 v113, v46, v81, v113
    v_dot2_f32_bf16 v114, v47, v73, v114
    v_dot2_f32_bf16 v115, v47, v81, v115
    v_dot2_f32_bf16 v108, v48, v74, v108
    v_dot2_f32_bf16 v109, v48, v82, v109
    v_dot2_f32_bf16 v110, v49, v74, v110
    v_dot2_f32_bf16 v111, v49, v82, v111
    v_dot2_f32_bf16 v112, v50, v74, v112
    v_dot2_f32_bf16 v113, v50, v82, v113
    v_dot2_f32_bf16 v114, v51, v74, v114
    v_dot2_f32_bf16 v115, v51, v82, v115
    v_dot2_f32_bf16 v108, v52, v75, v108
    v_dot2_f32_bf16 v109, v52, v83, v109
    v_dot2_f32_bf16 v110, v53, v75, v110
    v_dot2_f32_bf16 v111, v53, v83, v111
    v_dot2_f32_bf16 v112, v54, v75, v112
    v_dot2_f32_bf16 v113, v54, v83, v113
    v_dot2_f32_bf16 v114, v55, v75, v114
    v_dot2_f32_bf16 v115, v55, v83, v115
    s_nop 3
    v_lshrrev_b32 v126, 4, v0
    v_lshlrev_b32 v126, 2, v126
    ds_write_b32 v126, v116 offset:8192
    ds_read_b128 v[8:11], v2 offset:32768
    ds_read_b128 v[12:15], v2 offset:33792
    ds_read_b128 v[16:19], v2 offset:34816
    ds_read_b128 v[20:23], v2 offset:35840
    ds_read_b128 v[24:27], v2 offset:36864
    ds_read_b128 v[28:31], v2 offset:37888
    ds_read_b128 v[32:35], v2 offset:38912
    ds_read_b128 v[36:39], v2 offset:39936
    s_waitcnt lgkmcnt(0)
    s_barrier
    v_lshlrev_b32 v127, 2, v1
    ds_read_b32 v88, v127 offset:8192
    s_waitcnt lgkmcnt(0)
    s_nop 2
    v_max_f32_dpp v88, v88, v88 quad_perm:[1,0,3,2] row_mask:0xf bank_mask:0xf
    s_nop 2
    v_max_f32_dpp v88, v88, v88 quad_perm:[2,3,0,1] row_mask:0xf bank_mask:0xf
    s_nop 2
    v_max_f32_dpp v88, v88, v88 row_half_mirror row_mask:0xf bank_mask:0xf
    s_nop 2
    v_max_f32_dpp v88, v88, v88 row_mirror row_mask:0xf bank_mask:0xf
    s_nop 1
    v_readlane_b32 s52, v88, 0
    v_readlane_b32 s53, v88, 16
    v_readlane_b32 s54, v88, 32
    v_readlane_b32 s55, v88, 48
    s_nop 1
    v_mov_b32 v89, s52
    v_max_f32 v89, s53, v89
    v_max_f32 v89, s54, v89
    v_max_f32 v88, s55, v89
    v_sub_f32 v89, v116, v88
    v_mul_f32 v89, s46, v89
    v_exp_f32 v89, v89
    s_nop 0
    v_mul_f32 v108, v108, v89
    v_mul_f32 v109, v109, v89
    v_mul_f32 v110, v110, v89
    v_mul_f32 v111, v111, v89
    v_mul_f32 v112, v112, v89
    v_mul_f32 v113, v113, v89
    v_mul_f32 v114, v114, v89
    v_mul_f32 v115, v115, v89
    v_mul_f32 v117, v117, v89
    ds_write_b32 v126, v117 offset:8448
    v_mov_b32 v118, v108
    v_mov_b32 v119, v109
    v_mov_b32 v120, v110
    v_mov_b32 v121, v111
    v_mov_b32 v122, v112
    v_mov_b32 v123, v113
    v_mov_b32 v124, v114
    v_mov_b32 v125, v115
    s_nop 1
    v_permlane32_swap_b32 v118, v108
    v_permlane32_swap_b32 v119, v109
    v_permlane32_swap_b32 v120, v110
    v_permlane32_swap_b32 v121, v111
    v_permlane32_swap_b32 v122, v112
    v_permlane32_swap_b32 v123, v113
    v_permlane32_swap_b32 v124, v114
    v_permlane32_swap_b32 v125, v115
    s_nop 1
    v_add_f32 v108, v108, v118
    v_add_f32 v109, v109, v119
    v_add_f32 v110, v110, v120
    v_add_f32 v111, v111, v121
    v_add_f32 v112, v112, v122
    v_add_f32 v113, v113, v123
    v_add_f32 v114, v114, v124
    v_add_f32 v115, v115, v125
    v_bfe_u32 v72, v0, 4, 1
    s_lshl_b32 s45, s43, 1
    v_add_u32 v72, s45, v72
    v_lshlrev_b32 v72, 9, v72
    v_lshl_add_u32 v72, v7, 5, v72
    ds_write_b128 v72, v[108:111] offset:9216
    ds_write_b128 v72, v[112:115] offset:9232
    v_lshrrev_b32 v73, 7, v0
    v_lshlrev_b32 v73, 11, v73
    v_and_b32 v74, 127, v0
    v_lshl_add_u32 v73, v74, 2, v73
    s_waitcnt lgkmcnt(0)
    s_barrier
    ds_read_b32 v76, v73 offset:9216
    ds_read_b32 v77, v73 offset:9728
    ds_read_b32 v78, v73 offset:10240
    ds_read_b32 v79, v73 offset:10752
    s_waitcnt lgkmcnt(0)
    v_add_f32 v76, v76, v77
    v_add_f32 v78, v78, v79
    v_add_f32 v76, v76, v78
    ds_write_b32 v6, v76 offset:4096
    s_waitcnt lgkmcnt(0)
    s_barrier
    s_lshl_b32 s45, s43, 5
    v_mov_b32 v126, s45
    ds_read_b128 v[40:43], v126 offset:4096
    ds_read_b128 v[44:47], v126 offset:4112
    ds_read_b128 v[48:51], v126 offset:4608
    ds_read_b128 v[52:55], v126 offset:4624
    ds_read_b128 v[56:59], v126 offset:5120
    ds_read_b128 v[60:63], v126 offset:5136
    ds_read_b128 v[64:67], v126 offset:5632
    ds_read_b128 v[68:71], v126 offset:5648
    s_waitcnt lgkmcnt(0)
    v_add_f32 v40, v40, v48
    v_add_f32 v56, v56, v64
    v_add_f32 v41, v41, v49
    v_add_f32 v57, v57, v65
    v_add_f32 v42, v42, v50
    v_add_f32 v58, v58, v66
    v_add_f32 v43, v43, v51
    v_add_f32 v59, v59, v67
    v_add_f32 v44, v44, v52
    v_add_f32 v60, v60, v68
    v_add_f32 v45, v45, v53
    v_add_f32 v61, v61, v69
    v_add_f32 v46, v46, v54
    v_add_f32 v62, v62, v70
    v_add_f32 v47, v47, v55
    v_add_f32 v63, v63, v71
    v_add_f32 v118, v40, v56
    v_add_f32 v119, v41, v57
    v_add_f32 v120, v42, v58
    v_add_f32 v121, v43, v59
    v_add_f32 v122, v44, v60
    v_add_f32 v123, v45, v61
    v_add_f32 v124, v46, v62
    v_add_f32 v125, v47, v63
    ds_read_b128 v[40:43], v126 offset:6144
    ds_read_b128 v[44:47], v126 offset:6160
    ds_read_b128 v[48:51], v126 offset:6656
    ds_read_b128 v[52:55], v126 offset:6672
    ds_read_b128 v[56:59], v126 offset:7168
    ds_read_b128 v[60:63], v126 offset:7184
    ds_read_b128 v[64:67], v126 offset:7680
    ds_read_b128 v[68:71], v126 offset:7696
    s_waitcnt lgkmcnt(0)
    v_add_f32 v40, v40, v48
    v_add_f32 v56, v56, v64
    v_add_f32 v41, v41, v49
    v_add_f32 v57, v57, v65
    v_add_f32 v42, v42, v50
    v_add_f32 v58, v58, v66
    v_add_f32 v43, v43, v51
    v_add_f32 v59, v59, v67
    v_add_f32 v44, v44, v52
    v_add_f32 v60, v60, v68
    v_add_f32 v45, v45, v53
    v_add_f32 v61, v61, v69
    v_add_f32 v46, v46, v54
    v_add_f32 v62, v62, v70
    v_add_f32 v47, v47, v55
    v_add_f32 v63, v63, v71
    v_add_f32 v40, v40, v56
    v_add_f32 v118, v118, v40
    v_add_f32 v41, v41, v57
    v_add_f32 v119, v119, v41
    v_add_f32 v42, v42, v58
    v_add_f32 v120, v120, v42
    v_add_f32 v43, v43, v59
    v_add_f32 v121, v121, v43
    v_add_f32 v44, v44, v60
    v_add_f32 v122, v122, v44
    v_add_f32 v45, v45, v61
    v_add_f32 v123, v123, v45
    v_add_f32 v46, v46, v62
    v_add_f32 v124, v124, v46
    v_add_f32 v47, v47, v63
    v_add_f32 v125, v125, v47
    v_lshlrev_b32 v40, 16, v8
    v_and_b32 v41, 0xffff0000, v8
    v_lshlrev_b32 v42, 16, v9
    v_and_b32 v43, 0xffff0000, v9
    v_lshlrev_b32 v44, 16, v10
    v_and_b32 v45, 0xffff0000, v10
    v_lshlrev_b32 v46, 16, v11
    v_and_b32 v47, 0xffff0000, v11
    v_mul_f32 v108, v118, v40
    v_mul_f32 v109, v118, v41
    v_mul_f32 v110, v118, v42
    v_mul_f32 v111, v118, v43
    v_mul_f32 v112, v118, v44
    v_mul_f32 v113, v118, v45
    v_mul_f32 v114, v118, v46
    v_mul_f32 v115, v118, v47
    v_lshlrev_b32 v40, 16, v12
    v_and_b32 v41, 0xffff0000, v12
    v_lshlrev_b32 v42, 16, v13
    v_and_b32 v43, 0xffff0000, v13
    v_lshlrev_b32 v44, 16, v14
    v_and_b32 v45, 0xffff0000, v14
    v_lshlrev_b32 v46, 16, v15
    v_and_b32 v47, 0xffff0000, v15
    v_fma_f32 v108, v119, v40, v108
    v_fma_f32 v109, v119, v41, v109
    v_fma_f32 v110, v119, v42, v110
    v_fma_f32 v111, v119, v43, v111
    v_fma_f32 v112, v119, v44, v112
    v_fma_f32 v113, v119, v45, v113
    v_fma_f32 v114, v119, v46, v114
    v_fma_f32 v115, v119, v47, v115
    v_lshlrev_b32 v40, 16, v16
    v_and_b32 v41, 0xffff0000, v16
    v_lshlrev_b32 v42, 16, v17
    v_and_b32 v43, 0xffff0000, v17
    v_lshlrev_b32 v44, 16, v18
    v_and_b32 v45, 0xffff0000, v18
    v_lshlrev_b32 v46, 16, v19
    v_and_b32 v47, 0xffff0000, v19
    v_fma_f32 v108, v120, v40, v108
    v_fma_f32 v109, v120, v41, v109
    v_fma_f32 v110, v120, v42, v110
    v_fma_f32 v111, v120, v43, v111
    v_fma_f32 v112, v120, v44, v112
    v_fma_f32 v113, v120, v45, v113
    v_fma_f32 v114, v120, v46, v114
    v_fma_f32 v115, v120, v47, v115
    v_lshlrev_b32 v40, 16, v20
    v_and_b32 v41, 0xffff0000, v20
    v_lshlrev_b32 v42, 16, v21
    v_and_b32 v43, 0xffff0000, v21
    v_lshlrev_b32 v44, 16, v22
    v_and_b32 v45, 0xffff0000, v22
    v_lshlrev_b32 v46, 16, v23
    v_and_b32 v47, 0xffff0000, v23
    v_fma_f32 v108, v121, v40, v108
    v_fma_f32 v109, v121, v41, v109
    v_fma_f32 v110, v121, v42, v110
    v_fma_f32 v111, v121, v43, v111
    v_fma_f32 v112, v121, v44, v112
    v_fma_f32 v113, v121, v45, v113
    v_fma_f32 v114, v121, v46, v114
    v_fma_f32 v115, v121, v47, v115
    v_lshlrev_b32 v40, 16, v24
    v_and_b32 v41, 0xffff0000, v24
    v_lshlrev_b32 v42, 16, v25
    v_and_b32 v43, 0xffff0000, v25
    v_lshlrev_b32 v44, 16, v26
    v_and_b32 v45, 0xffff0000, v26
    v_lshlrev_b32 v46, 16, v27
    v_and_b32 v47, 0xffff0000, v27
    v_fma_f32 v108, v122, v40, v108
    v_fma_f32 v109, v122, v41, v109
    v_fma_f32 v110, v122, v42, v110
    v_fma_f32 v111, v122, v43, v111
    v_fma_f32 v112, v122, v44, v112
    v_fma_f32 v113, v122, v45, v113
    v_fma_f32 v114, v122, v46, v114
    v_fma_f32 v115, v122, v47, v115
    v_lshlrev_b32 v40, 16, v28
    v_and_b32 v41, 0xffff0000, v28
    v_lshlrev_b32 v42, 16, v29
    v_and_b32 v43, 0xffff0000, v29
    v_lshlrev_b32 v44, 16, v30
    v_and_b32 v45, 0xffff0000, v30
    v_lshlrev_b32 v46, 16, v31
    v_and_b32 v47, 0xffff0000, v31
    v_fma_f32 v108, v123, v40, v108
    v_fma_f32 v109, v123, v41, v109
    v_fma_f32 v110, v123, v42, v110
    v_fma_f32 v111, v123, v43, v111
    v_fma_f32 v112, v123, v44, v112
    v_fma_f32 v113, v123, v45, v113
    v_fma_f32 v114, v123, v46, v114
    v_fma_f32 v115, v123, v47, v115
    v_lshlrev_b32 v40, 16, v32
    v_and_b32 v41, 0xffff0000, v32
    v_lshlrev_b32 v42, 16, v33
    v_and_b32 v43, 0xffff0000, v33
    v_lshlrev_b32 v44, 16, v34
    v_and_b32 v45, 0xffff0000, v34
    v_lshlrev_b32 v46, 16, v35
    v_and_b32 v47, 0xffff0000, v35
    v_fma_f32 v108, v124, v40, v108
    v_fma_f32 v109, v124, v41, v109
    v_fma_f32 v110, v124, v42, v110
    v_fma_f32 v111, v124, v43, v111
    v_fma_f32 v112, v124, v44, v112
    v_fma_f32 v113, v124, v45, v113
    v_fma_f32 v114, v124, v46, v114
    v_fma_f32 v115, v124, v47, v115
    v_lshlrev_b32 v40, 16, v36
    v_and_b32 v41, 0xffff0000, v36
    v_lshlrev_b32 v42, 16, v37
    v_and_b32 v43, 0xffff0000, v37
    v_lshlrev_b32 v44, 16, v38
    v_and_b32 v45, 0xffff0000, v38
    v_lshlrev_b32 v46, 16, v39
    v_and_b32 v47, 0xffff0000, v39
    v_fma_f32 v108, v125, v40, v108
    v_fma_f32 v109, v125, v41, v109
    v_fma_f32 v110, v125, v42, v110
    v_fma_f32 v111, v125, v43, v111
    v_fma_f32 v112, v125, v44, v112
    v_fma_f32 v113, v125, v45, v113
    v_fma_f32 v114, v125, v46, v114
    v_fma_f32 v115, v125, v47, v115
    s_lshl_b32 s45, s43, 13
    v_lshlrev_b32 v126, 5, v1
    v_add_u32 v126, s45, v126
    ds_write_b128 v126, v[108:111] offset:32768
    ds_write_b128 v126, v[112:115] offset:32784
    s_waitcnt lgkmcnt(0)
    s_barrier
    s_cmp_ge_u32 s43, 9
    s_cbranch_scc1 KA_END
    s_cmp_eq_u32 s43, 8
    s_cbranch_scc1 KA_LSUM
    v_add_u32 v40, 32768, v6
    v_add_u32 v41, 65536, v6
    v_add_u32 v42, 98304, v6
    v_add_u32 v43, 131072, v6
    ds_read_b32 v72, v40 offset:0
    ds_read_b32 v73, v40 offset:8192
    ds_read_b32 v74, v40 offset:16384
    ds_read_b32 v75, v40 offset:24576
    ds_read_b32 v76, v41 offset:0
    ds_read_b32 v77, v41 offset:8192
    ds_read_b32 v78, v41 offset:16384
    ds_read_b32 v79, v41 offset:24576
    ds_read_b32 v80, v42 offset:0
    ds_read_b32 v81, v42 offset:8192
    ds_read_b32 v82, v42 offset:16384
    ds_read_b32 v83, v42 offset:24576
    ds_read_b32 v84, v43 offset:0
    ds_read_b32 v85, v43 offset:8192
    ds_read_b32 v86, v43 offset:16384
    ds_read_b32 v87, v43 offset:24576
    s_waitcnt lgkmcnt(0)
    v_add_f32 v72, v72, v80
    v_add_f32 v73, v73, v81
    v_add_f32 v74, v74, v82
    v_add_f32 v75, v75, v83
    v_add_f32 v76, v76, v84
    v_add_f32 v77, v77, v85
    v_add_f32 v78, v78, v86
    v_add_f32 v79, v79, v87
    v_add_f32 v72, v72, v76
    v_add_f32 v73, v73, v77
    v_add_f32 v74, v74, v78
    v_add_f32 v75, v75, v79
    v_add_f32 v72, v72, v74
    v_add_f32 v73, v73, v75
    v_add_f32 v72, v72, v73
    s_lshl_b32 s45, s50, 11
    s_add_u32 s45, s45, 1048576
    buffer_store_dword v72, v6, s[36:39], s45 offen
    s_branch KA_END
KA_LSUM:
    ds_read_b32 v89, v127 offset:8448
    s_waitcnt lgkmcnt(0)
    s_nop 2
    v_add_f32_dpp v89, v89, v89 quad_perm:[1,0,3,2] row_mask:0xf bank_mask:0xf
    s_nop 2
    v_add_f32_dpp v89, v89, v89 quad_perm:[2,3,0,1] row_mask:0xf bank_mask:0xf
    s_nop 2
    v_add_f32_dpp v89, v89, v89 row_half_mirror row_mask:0xf bank_mask:0xf
    s_nop 2
    v_add_f32_dpp v89, v89, v89 row_mirror row_mask:0xf bank_mask:0xf
    s_nop 1
    v_readlane_b32 s52, v89, 0
    v_readlane_b32 s53, v89, 16
    v_readlane_b32 s54, v89, 32
    v_readlane_b32 s55, v89, 48
    s_nop 1
    v_mov_b32 v90, s52
    v_add_f32 v90, s53, v90
    v_add_f32 v90, s54, v90
    v_add_f32 v89, s55, v90
    s_lshl_b32 s45, s50, 3
    s_add_u32 s45, s45, 131072
    v_mov_b32 v90, 0
    s_mov_b64 exec, 1
    buffer_store_dwordx2 v[88:89], v90, s[36:39], s45 offen
KA_END:
    s_endpgm
.globl decode_final_kernel
.p2align 8
.type decode_final_kernel,@function
decode_final_kernel:
    s_cmp_ge_u32 s2, 32
    s_cbranch_scc1 KF_END
    s_load_dwordx2 s[4:5], s[0:1], 0
    s_load_dwordx2 s[10:11], s[0:1], 72
    s_load_dwordx2 s[12:13], s[0:1], 88
    s_load_dwordx2 s[14:15], s[0:1], 80
    s_lshr_b32 s41, s2, 4
    s_and_b32 s40, s2, 15
    v_and_b32 v1, 31, v0
    v_lshrrev_b32 v2, 5, v0
    v_lshlrev_b32 v3, 15, v2
    v_lshl_add_u32 v3, v1, 2, v3
    v_lshlrev_b32 v4, 7, v2
    v_lshlrev_b32 v5, 12, v2
    v_lshl_add_u32 v5, v1, 2, v5
    s_lshl_b32 s44, s41, 18
    s_lshl_b32 s45, s40, 7
    s_add_u32 s44, s44, s45
    s_add_u32 s44, s44, 1048576
    s_lshl_b32 s46, s41, 10
    s_add_u32 s46, s46, 131072
    s_lshl_b32 s47, s41, 11
    s_add_u32 s47, s47, s45
    s_waitcnt lgkmcnt(0)
    s_mov_b32 s20, s12
    s_mov_b32 s21, s13
    s_mov_b32 s22, 3145728
    s_mov_b32 s23, 0x20000
    s_add_u32 s32, s12, 2097152
    s_addc_u32 s33, s13, 0
    s_mov_b32 s34, 176128
    s_mov_b32 s35, 0x20000
    s_mov_b32 s24, s4
    s_mov_b32 s25, s5
    s_mov_b32 s26, 2048
    s_mov_b32 s27, 0x20000
    s_mov_b32 s28, s10
    s_mov_b32 s29, s11
    s_mov_b32 s30, 2048
    s_mov_b32 s31, 0x20000
    buffer_load_dwordx4 v[24:27], v4, s[20:23], s46 offen offset:0
    buffer_load_dwordx4 v[28:31], v4, s[20:23], s46 offen offset:16
    buffer_load_dwordx4 v[32:35], v4, s[20:23], s46 offen offset:32
    buffer_load_dwordx4 v[36:39], v4, s[20:23], s46 offen offset:48
    buffer_load_dwordx4 v[40:43], v4, s[20:23], s46 offen offset:64
    buffer_load_dwordx4 v[44:47], v4, s[20:23], s46 offen offset:80
    buffer_load_dwordx4 v[48:51], v4, s[20:23], s46 offen offset:96
    buffer_load_dwordx4 v[52:55], v4, s[20:23], s46 offen offset:112
    buffer_load_dword v8, v3, s[20:23], s44 offen offset:0
    buffer_load_dword v9, v3, s[20:23], s44 offen offset:2048
    s_add_u32 s44, s44, 0x1000
    buffer_load_dword v10, v3, s[20:23], s44 offen offset:0
    buffer_load_dword v11, v3, s[20:23], s44 offen offset:2048
    s_add_u32 s44, s44, 0x1000
    buffer_load_dword v12, v3, s[20:23], s44 offen offset:0
    buffer_load_dword v13, v3, s[20:23], s44 offen offset:2048
    s_add_u32 s44, s44, 0x1000
    buffer_load_dword v14, v3, s[20:23], s44 offen offset:0
    buffer_load_dword v15, v3, s[20:23], s44 offen offset:2048
    s_add_u32 s44, s44, 0x1000
    buffer_load_dword v16, v3, s[20:23], s44 offen offset:0
    buffer_load_dword v17, v3, s[20:23], s44 offen offset:2048
    s_add_u32 s44, s44, 0x1000
    buffer_load_dword v18, v3, s[20:23], s44 offen offset:0
    buffer_load_dword v19, v3, s[20:23], s44 offen offset:2048
    s_add_u32 s44, s44, 0x1000
    buffer_load_dword v20, v3, s[20:23], s44 offen offset:0
    buffer_load_dword v21, v3, s[20:23], s44 offen offset:2048
    s_add_u32 s44, s44, 0x1000
    buffer_load_dword v22, v3, s[20:23], s44 offen offset:0
    buffer_load_dword v23, v3, s[20:23], s44 offen offset:2048
    buffer_load_dword v56, v5, s[32:35], s47 offen
    v_add_u32 v5, 0x8000, v5
    buffer_load_dword v57, v5, s[32:35], s47 offen
    v_add_u32 v5, 0x8000, v5
    buffer_load_dword v58, v5, s[32:35], s47 offen
    v_add_u32 v5, 0x8000, v5
    buffer_load_dword v59, v5, s[32:35], s47 offen
    v_add_u32 v5, 0x8000, v5
    buffer_load_dword v60, v5, s[32:35], s47 offen
    v_add_u32 v5, 0x8000, v5
    buffer_load_dword v61, v5, s[32:35], s47 offen
    s_lshl_b32 s48, s41, 10
    s_lshl_b32 s49, s40, 6
    s_add_u32 s48, s48, s49
    v_lshlrev_b32 v6, 1, v1
    buffer_load_ushort v79, v6, s[24:27], s48 offen
    s_mov_b32 s50, 0x3fb8aa3b
    s_waitcnt vmcnt(23)
    v_max3_f32 v64, v24, v26, v28
    v_max_f32 v64, v64, v30
    v_sub_f32 v24, v24, v64
    v_sub_f32 v26, v26, v64
    v_sub_f32 v28, v28, v64
    v_sub_f32 v30, v30, v64
    v_mul_f32 v24, s50, v24
    v_mul_f32 v26, s50, v26
    v_mul_f32 v28, s50, v28
    v_mul_f32 v30, s50, v30
    v_exp_f32 v24, v24
    v_exp_f32 v26, v26
    v_exp_f32 v28, v28
    v_exp_f32 v30, v30
    s_nop 0
    v_mul_f32 v64, v25, v24
    v_fma_f32 v64, v27, v26, v64
    v_fma_f32 v64, v29, v28, v64
    v_fma_f32 v64, v31, v30, v64
    v_rcp_f32 v64, v64
    s_nop 0
    v_mul_f32 v24, v24, v64
    v_mul_f32 v26, v26, v64
    v_mul_f32 v28, v28, v64
    v_mul_f32 v30, v30, v64
    v_max3_f32 v64, v32, v34, v36
    v_max_f32 v64, v64, v38
    v_sub_f32 v32, v32, v64
    v_sub_f32 v34, v34, v64
    v_sub_f32 v36, v36, v64
    v_sub_f32 v38, v38, v64
    v_mul_f32 v32, s50, v32
    v_mul_f32 v34, s50, v34
    v_mul_f32 v36, s50, v36
    v_mul_f32 v38, s50, v38
    v_exp_f32 v32, v32
    v_exp_f32 v34, v34
    v_exp_f32 v36, v36
    v_exp_f32 v38, v38
    s_nop 0
    v_mul_f32 v64, v33, v32
    v_fma_f32 v64, v35, v34, v64
    v_fma_f32 v64, v37, v36, v64
    v_fma_f32 v64, v39, v38, v64
    v_rcp_f32 v64, v64
    s_nop 0
    v_mul_f32 v32, v32, v64
    v_mul_f32 v34, v34, v64
    v_mul_f32 v36, v36, v64
    v_mul_f32 v38, v38, v64
    v_max3_f32 v64, v40, v42, v44
    v_max_f32 v64, v64, v46
    v_sub_f32 v40, v40, v64
    v_sub_f32 v42, v42, v64
    v_sub_f32 v44, v44, v64
    v_sub_f32 v46, v46, v64
    v_mul_f32 v40, s50, v40
    v_mul_f32 v42, s50, v42
    v_mul_f32 v44, s50, v44
    v_mul_f32 v46, s50, v46
    v_exp_f32 v40, v40
    v_exp_f32 v42, v42
    v_exp_f32 v44, v44
    v_exp_f32 v46, v46
    s_nop 0
    v_mul_f32 v64, v41, v40
    v_fma_f32 v64, v43, v42, v64
    v_fma_f32 v64, v45, v44, v64
    v_fma_f32 v64, v47, v46, v64
    v_rcp_f32 v64, v64
    s_nop 0
    v_mul_f32 v40, v40, v64
    v_mul_f32 v42, v42, v64
    v_mul_f32 v44, v44, v64
    v_mul_f32 v46, v46, v64
    v_max3_f32 v64, v48, v50, v52
    v_max_f32 v64, v64, v54
    v_sub_f32 v48, v48, v64
    v_sub_f32 v50, v50, v64
    v_sub_f32 v52, v52, v64
    v_sub_f32 v54, v54, v64
    v_mul_f32 v48, s50, v48
    v_mul_f32 v50, s50, v50
    v_mul_f32 v52, s50, v52
    v_mul_f32 v54, s50, v54
    v_exp_f32 v48, v48
    v_exp_f32 v50, v50
    v_exp_f32 v52, v52
    v_exp_f32 v54, v54
    s_nop 0
    v_mul_f32 v64, v49, v48
    v_fma_f32 v64, v51, v50, v64
    v_fma_f32 v64, v53, v52, v64
    v_fma_f32 v64, v55, v54, v64
    v_rcp_f32 v64, v64
    s_nop 0
    v_mul_f32 v48, v48, v64
    v_mul_f32 v50, v50, v64
    v_mul_f32 v52, v52, v64
    v_mul_f32 v54, v54, v64
    s_waitcnt vmcnt(1)
    v_mul_f32 v64, v8, v24
    v_fma_f32 v64, v9, v26, v64
    v_fma_f32 v64, v10, v28, v64
    v_fma_f32 v64, v11, v30, v64
    v_fma_f32 v64, v12, v32, v64
    v_fma_f32 v64, v13, v34, v64
    v_fma_f32 v64, v14, v36, v64
    v_fma_f32 v64, v15, v38, v64
    v_fma_f32 v64, v16, v40, v64
    v_fma_f32 v64, v17, v42, v64
    v_fma_f32 v64, v18, v44, v64
    v_fma_f32 v64, v19, v46, v64
    v_fma_f32 v64, v20, v48, v64
    v_fma_f32 v64, v21, v50, v64
    v_fma_f32 v64, v22, v52, v64
    v_fma_f32 v64, v23, v54, v64
    v_add_f32 v56, v56, v57
    v_add_f32 v58, v58, v59
    v_add_f32 v60, v60, v61
    v_add_f32 v56, v56, v58
    v_add_f32 v65, v56, v60
    v_lshlrev_b32 v7, 3, v0
    ds_write_b64 v7, v[64:65]
    s_waitcnt lgkmcnt(0)
    s_barrier
    v_cmp_gt_u32 vcc, 32, v0
    s_and_saveexec_b64 s[52:53], vcc
    s_cbranch_execz KF_END
    ds_read_b64 v[8:9], v7 offset:0
    ds_read_b64 v[10:11], v7 offset:256
    ds_read_b64 v[12:13], v7 offset:512
    ds_read_b64 v[14:15], v7 offset:768
    ds_read_b64 v[16:17], v7 offset:1024
    ds_read_b64 v[18:19], v7 offset:1280
    ds_read_b64 v[20:21], v7 offset:1536
    ds_read_b64 v[22:23], v7 offset:1792
    s_waitcnt lgkmcnt(0)
    v_add_f32 v8, v8, v16
    v_add_f32 v9, v9, v17
    v_add_f32 v10, v10, v18
    v_add_f32 v11, v11, v19
    v_add_f32 v12, v12, v20
    v_add_f32 v13, v13, v21
    v_add_f32 v14, v14, v22
    v_add_f32 v15, v15, v23
    v_add_f32 v8, v8, v12
    v_add_f32 v9, v9, v13
    v_add_f32 v10, v10, v14
    v_add_f32 v11, v11, v15
    v_add_f32 v8, v8, v10
    v_add_f32 v9, v9, v11
    v_cvt_pk_bf16_f32 v66, v8, v8
    v_lshlrev_b32 v8, 16, v66
    v_cvt_pk_bf16_f32 v66, v9, v9
    v_lshlrev_b32 v9, 16, v66
    v_mul_f32 v66, 0xbfb8aa3b, v9
    v_exp_f32 v66, v66
    s_nop 0
    v_add_f32 v66, 1.0, v66
    v_rcp_f32 v66, v66
    s_nop 0
    v_mul_f32 v66, v66, v9
    v_cvt_pk_bf16_f32 v67, v66, v66
    v_lshlrev_b32 v66, 16, v67
    v_mul_f32 v66, v66, v8
    v_cvt_pk_bf16_f32 v67, v66, v66
    v_lshlrev_b32 v66, 16, v67
    s_waitcnt vmcnt(0)
    v_lshlrev_b32 v79, 16, v79
    v_add_f32 v66, v79, v66
    v_cvt_pk_bf16_f32 v66, v66, v66
    buffer_store_short v66, v6, s[28:31], s48 offen
KF_END:
    s_endpgm
.section .rodata,"a"
.p2align 6
.amdhsa_kernel recurrent_scan__mha_block_cached__geglu_ffn__decode_kernel
  .amdhsa_next_free_vgpr 128
  .amdhsa_next_free_sgpr 102
  .amdhsa_accum_offset 128
  .amdhsa_group_segment_fixed_size 0
  .amdhsa_kernarg_size 96
  .amdhsa_user_sgpr_count 2
  .amdhsa_user_sgpr_kernarg_segment_ptr 1
  .amdhsa_system_sgpr_workgroup_id_x 1
.end_amdhsa_kernel
.p2align 6
.amdhsa_kernel decode_final_kernel
  .amdhsa_next_free_vgpr 80
  .amdhsa_next_free_sgpr 102
  .amdhsa_accum_offset 80
  .amdhsa_group_segment_fixed_size 0
  .amdhsa_kernarg_size 96
  .amdhsa_user_sgpr_count 2
  .amdhsa_user_sgpr_kernarg_segment_ptr 1
  .amdhsa_system_sgpr_workgroup_id_x 1
.end_amdhsa_kernel
```
